```python
import torch

def _softmax(x, axis=-1):
    return torch.softmax(x, dim=axis)
def _gelu(x):
    return torch.nn.functional.gelu(x, approximate="tanh")
def _silu(x):
    return torch.nn.functional.silu(x)
def _sigmoid(x):
    return torch.sigmoid(x)
def _layernorm(x, axis=-1, eps=1e-5):
    m = x.mean(dim=axis, keepdim=True)
    v = x.var(dim=axis, keepdim=True, unbiased=False)
    return (x - m) / torch.sqrt(v + eps)
def _scatter_add(tgt, idx, src, axis=0):
    return tgt.clone().index_add_(axis, idx, src)
def _segment_sum(src, seg, n):
    out = torch.zeros((n,) + src.shape[1:], dtype=src.dtype)
    return out.index_add_(0, seg, src)
def _pad(x, pw):
    flat = tuple(v for pair in reversed(pw) for v in pair)
    return torch.nn.functional.pad(x, flat)

kernel_name = 'standalone__deepnorm__sampling'

def setup_inputs():

    _w = (lambda a: (lambda t: t.to(torch.bfloat16) if t.is_floating_point() else t)(torch.as_tensor(a)))
    B, S, D = 1024, 32, 512
    return {
        "x": _w((lambda *s: torch.randn(*s, dtype=torch.bfloat16) * 0.05)(B, S, D)),
        "f": _w((lambda *s: torch.randn(*s, dtype=torch.bfloat16) * 0.05)(B, S, D)),
        "g": _w((lambda *s: torch.randn(*s, dtype=torch.bfloat16) * 0.05)(D) + 1.0),
        "b": _w((lambda *s: torch.randn(*s, dtype=torch.bfloat16) * 0.4)(D)),
        "alpha": _w(float(2.0)),
    }

def reference(x, f, g, b, alpha):
    return _layernorm(alpha * x + f, axis=-1) * g + b
```

```asm
; @launch grid=(8192,1,1) block=(256,1,1) lds=0
.amdgcn_target "amdgcn-amd-amdhsa--gfx950"
.text
.globl standalone__deepnorm__sampling_kernel
.p2align 8
.type standalone__deepnorm__sampling_kernel,@function
standalone__deepnorm__sampling_kernel:
    s_load_dwordx8 s[4:11], s[0:1], 0
    s_load_dwordx4 s[12:15], s[0:1], 32
    s_load_dwordx2 s[36:37], s[0:1], 48
    s_cmp_ge_u32 s2, 8192
    s_cbranch_scc1 L_done
    s_lshl_b32 s3, s2, 12
    s_and_b32 s3, s3, 0xfffe0000
    s_and_b32 s39, s2, 3
    s_lshl_b32 s45, s39, 15
    s_or_b32 s3, s3, s45
    s_lshl_b32 s45, s2, 9
    s_and_b32 s45, s45, 0x1000
    s_or_b32 s3, s3, s45
    s_lshl_b32 s45, s2, 10
    s_and_b32 s45, s45, 0x4000
    s_or_b32 s3, s3, s45
    s_lshl_b32 s38, s2, 8
    s_lshl_b32 s19, s2, 11
    v_lshlrev_b32 v2, 4, v0
    v_and_b32 v1, 0x3f0, v2
    s_mov_b32 s56, 0
    s_cmp_ge_u32 s2, 2304
    s_cbranch_scc1 L_dynamic
    s_cmp_le_u32 s2, 48
    s_cbranch_scc1 L_probe
    s_waitcnt lgkmcnt(0)
L_go0:
    global_load_dwordx4 v[4:7], v1, s[8:9]
    global_load_dwordx4 v[12:15], v1, s[10:11]
L_go:
    s_xor_b32 s38, s38, s19
    s_and_b32 s38, s38, 0x2000
    s_or_b32 s3, s3, s38
    v_add_u32 v2, s3, v2
    global_load_dwordx4 v[28:31], v2, s[4:5] nt
    global_load_dwordx4 v[32:35], v2, s[6:7] nt
    s_load_dword s16, s[12:13], 0
    s_branch L_main
L_dynamic:
    s_cmp_ge_u32 s2, 3584
    s_cselect_b32 s46, 128, 0
    s_waitcnt lgkmcnt(0)
    s_load_dwordx4 s[40:43], s[36:37], s46
    global_load_dwordx4 v[4:7], v1, s[8:9]
    global_load_dwordx4 v[12:15], v1, s[10:11]
    s_add_u32 s48, s4, s3
    s_lshr_b32 s45, s48, 8
    s_xor_b32 s48, s48, s45
    s_lshr_b32 s48, s48, 13
    s_add_u32 s49, s6, s3
    s_lshr_b32 s45, s49, 8
    s_xor_b32 s49, s49, s45
    s_lshr_b32 s49, s49, 13
    s_add_u32 s50, s14, s3
    s_lshr_b32 s45, s50, 8
    s_xor_b32 s50, s50, s45
    s_lshr_b32 s50, s50, 13
    s_mov_b32 s47, 0x40000001
    s_mov_b32 s51, 0x1ffff
    s_waitcnt lgkmcnt(0)
    s_min_u32 s45, s40, s41
    s_min_u32 s44, s42, s43
    s_min_u32 s45, s45, s44
    s_cmp_lt_u32 s45, 0x40000000
    s_cbranch_scc1 L_slow
L_decode:
    s_sub_u32 s40, s40, s47
    s_sub_u32 s41, s41, s47
    s_sub_u32 s42, s42, s47
    s_sub_u32 s43, s43, s47
    s_max_u32 s45, s40, s41
    s_max_u32 s44, s42, s43
    s_max_u32 s45, s45, s44
    s_cmp_ge_u32 s45, 0x3ffffff
    s_cbranch_scc1 L_go
    s_cmp_lt_u32 s40, s51
    s_addc_u32 s48, s48, 0
    s_and_b32 s48, s48, 1
    s_cmp_lt_u32 s41, s51
    s_addc_u32 s49, s49, 0
    s_and_b32 s49, s49, 1
    s_cmp_lt_u32 s42, s51
    s_addc_u32 s50, s50, 0
    s_and_b32 s50, s50, 1
    s_add_u32 s38, s48, s49
    s_add_u32 s38, s38, s50
    s_add_u32 s43, s43, s39
    s_lshl_b32 s38, s38, 12
    s_lshl_b32 s43, s43, 11
    s_xor_b32 s38, s38, s43
    s_branch L_go
L_probe:
    v_readfirstlane_b32 s43, v0
    s_getreg_b32 s55, hwreg(HW_REG_XCC_ID)
    s_lshr_b32 s45, s2, 4
    s_lshl_b32 s46, s2, 10
    s_andn2_b32 s47, s2, 8
    s_and_b32 s46, s46, 0x2000
    s_mul_i32 s47, s47, 0x8500
    s_and_b32 s47, s47, 0xfff9fff
    s_add_u32 s46, s46, s47
    s_add_u32 s46, s46, 0x1c04000
    s_cmp_lg_u32 s43, 0
    s_waitcnt lgkmcnt(0)
    s_cbranch_scc1 L_go0
    s_cmp_eq_u32 s45, 3
    s_cbranch_scc1 L_side
    s_memtime s[48:49]
    s_cmp_eq_u32 s45, 0
    s_cselect_b64 s[40:41], s[4:5], s[6:7]
    s_cmp_ge_u32 s45, 2
    s_cselect_b64 s[40:41], s[14:15], s[40:41]
    s_load_dword s47, s[40:41], s46 glc
    s_add_u32 s52, s40, s46
    s_lshr_b32 s53, s52, 8
    s_xor_b32 s52, s52, s53
    s_lshl_b32 s53, s55, 11
    s_xor_b32 s52, s52, s53
    s_waitcnt lgkmcnt(0)
    s_memtime s[42:43]
    s_load_dword s47, s[40:41], s46 glc
    s_waitcnt lgkmcnt(0)
    s_memtime s[50:51]
    s_sub_u32 s48, s42, s48
    s_min_u32 s48, s48, 2560
    s_waitcnt lgkmcnt(0)
    s_sub_u32 s42, s50, s42
    s_min_u32 s42, s42, 2047
    s_add_u32 s48, s48, s42
    s_sub_u32 s49, 0, s48
    s_bitcmp1_b32 s52, 13
    s_cselect_b32 s48, s48, s49
    s_add_u32 s56, s48, 0x4002000
L_report:
    s_lshl_b32 s57, s45, 2
    s_atomic_add s56, s[36:37], s57
    s_branch L_go0
L_side:
    s_and_b32 s55, s55, 7
    s_add_u32 s56, s55, 0x40000001
    s_branch L_report
L_main:
    s_mov_b32 s20, 0x3f80
    s_mov_b32 s21, 0
    s_mov_b32 s17, 0
    v_lshlrev_b64 v[16:17], v1, s[20:21]
    s_mov_b32 s18, 0xffff0000
    v_mov_b32 v25, 0x3b000000
    v_mov_b32 v26, 0x3727c5ac
    s_waitcnt vmcnt(2)
    v_mfma_f32_4x4x4_16b_bf16 v[36:39], v[16:17], v[4:5], 0
    v_mfma_f32_4x4x4_16b_bf16 v[40:43], v[16:17], v[6:7], 0
    v_mfma_f32_4x4x4_16b_bf16 v[44:47], v[16:17], v[12:13], 0
    v_mfma_f32_4x4x4_16b_bf16 v[48:51], v[16:17], v[14:15], 0
    s_waitcnt lgkmcnt(0)
    s_and_b32 s16, s16, 0xffff
    v_lshlrev_b64 v[18:19], v1, s[16:17]
    v_mov_b32 v12, 0x3f803f80
    v_mov_b32 v13, 0x3f803f80
    s_cmp_eq_u32 s56, 0
    s_cbranch_scc1 L_row
    s_add_u32 s57, s57, 128
    s_atomic_add s56, s[36:37], s57
L_row:
    s_waitcnt vmcnt(1)
    v_mfma_f32_4x4x4_16b_bf16 v[4:7], v[18:19], v[28:29], 0
    v_mfma_f32_4x4x4_16b_bf16 v[8:11], v[18:19], v[30:31], 0
    s_waitcnt vmcnt(0)
    v_mfma_f32_4x4x4_16b_bf16 v[4:7], v[16:17], v[32:33], v[4:7]
    s_nop 0
    v_mfma_f32_4x4x4_16b_bf16 v[8:11], v[16:17], v[34:35], v[8:11]
    s_nop 2
    v_cvt_pk_bf16_f32 v28, v4, v5
    v_cvt_pk_bf16_f32 v29, v6, v7
    v_cvt_pk_bf16_f32 v30, v8, v9
    v_cvt_pk_bf16_f32 v31, v10, v11
    v_mfma_f32_16x16x16_bf16 v[20:23], v[12:13], v[28:29], 0
    s_nop 0
    v_mfma_f32_16x16x16_bf16 v[20:23], v[12:13], v[30:31], v[20:23]
    v_mfma_f32_4x4x4_16b_bf16 v[4:7], v[16:17], v[28:29], 0
    v_mfma_f32_4x4x4_16b_bf16 v[8:11], v[16:17], v[30:31], 0
    s_nop 3
    s_nop 1
    v_add_f32_dpp v20, v20, v20 quad_perm:[1,0,3,2] row_mask:0xf bank_mask:0xf
    s_nop 1
    v_add_f32_dpp v20, v20, v20 quad_perm:[2,3,0,1] row_mask:0xf bank_mask:0xf
    s_nop 1
    v_add_f32_dpp v20, v20, v20 row_half_mirror row_mask:0xf bank_mask:0xf
    s_nop 1
    v_add_f32_dpp v20, v20, v20 row_mirror row_mask:0xf bank_mask:0xf
    v_mul_f32 v23, v25, v20
    v_cvt_pk_bf16_f32 v22, v23, v23
    v_and_b32 v22, s18, v22
    v_sub_f32 v23, v23, v22
    v_pk_add_f32 v[4:5], v[4:5], v[22:23] op_sel_hi:[1,0] neg_lo:[0,1] neg_hi:[0,1]
    v_pk_add_f32 v[6:7], v[6:7], v[22:23] op_sel_hi:[1,0] neg_lo:[0,1] neg_hi:[0,1]
    v_pk_add_f32 v[8:9], v[8:9], v[22:23] op_sel_hi:[1,0] neg_lo:[0,1] neg_hi:[0,1]
    v_pk_add_f32 v[10:11], v[10:11], v[22:23] op_sel_hi:[1,0] neg_lo:[0,1] neg_hi:[0,1]
    v_fma_f32 v27, -v23, v23, v26
    v_pk_mul_f32 v[20:21], v[4:5], v[4:5]
    v_pk_mul_f32 v[22:23], v[6:7], v[6:7]
    v_pk_fma_f32 v[20:21], v[8:9], v[8:9], v[20:21]
    v_pk_fma_f32 v[22:23], v[10:11], v[10:11], v[22:23]
    v_pk_add_f32 v[20:21], v[20:21], v[22:23]
    v_add_f32 v20, v20, v21
    v_pk_mul_f32 v[4:5], v[4:5], v[36:37]
    v_pk_mul_f32 v[6:7], v[6:7], v[38:39]
    v_add_f32_dpp v20, v20, v20 quad_perm:[1,0,3,2] row_mask:0xf bank_mask:0xf
    v_pk_mul_f32 v[8:9], v[8:9], v[40:41]
    v_pk_mul_f32 v[10:11], v[10:11], v[42:43]
    v_add_f32_dpp v20, v20, v20 quad_perm:[2,3,0,1] row_mask:0xf bank_mask:0xf
    s_nop 1
    v_add_f32_dpp v20, v20, v20 row_half_mirror row_mask:0xf bank_mask:0xf
    s_nop 1
    v_add_f32_dpp v20, v20, v20 row_mirror row_mask:0xf bank_mask:0xf
    s_nop 1
    v_add_f32_dpp v20, v20, v20 row_bcast:15 row_mask:0xa bank_mask:0xf
    s_nop 1
    v_add_f32_dpp v20, v20, v20 row_bcast:31 row_mask:0xc bank_mask:0xf
    v_fma_f32 v20, v20, v25, v27
    v_rsq_f32 v20, v20
    s_nop 0
    v_readlane_b32 s22, v20, 63
    s_nop 1
    v_pk_fma_f32 v[4:5], v[4:5], s[22:23], v[44:45] op_sel_hi:[1,0,1]
    v_pk_fma_f32 v[6:7], v[6:7], s[22:23], v[46:47] op_sel_hi:[1,0,1]
    v_pk_fma_f32 v[8:9], v[8:9], s[22:23], v[48:49] op_sel_hi:[1,0,1]
    v_pk_fma_f32 v[10:11], v[10:11], s[22:23], v[50:51] op_sel_hi:[1,0,1]
    v_cvt_pk_bf16_f32 v28, v4, v5
    v_cvt_pk_bf16_f32 v29, v6, v7
    v_cvt_pk_bf16_f32 v30, v8, v9
    v_cvt_pk_bf16_f32 v31, v10, v11
    global_store_dwordx4 v2, v[28:31], s[14:15] sc0 sc1
L_done:
    s_endpgm
L_slow:
    v_readfirstlane_b32 s45, v0
    s_mov_b64 exec, 15
    v_lshrrev_b32 v3, 2, v1
    v_add_u32 v3, s46, v3
    v_mov_b32 v21, 0x40000000
    s_and_b32 s44, s2, 0x78
    s_or_b32 s44, s44, s45
    s_cselect_b32 s44, 8, 1
L_poll:
    global_load_dword v20, v3, s[36:37] sc1
    s_waitcnt vmcnt(0)
    v_cmp_gt_u32 vcc, v21, v20
    s_cbranch_vccz L_have
    s_sub_u32 s44, s44, 1
    s_cbranch_scc1 L_close
    s_sleep 16
    s_branch L_poll
L_close:
    global_atomic_umax v20, v3, v21, s[36:37] sc0 sc1
    s_waitcnt vmcnt(0)
L_have:
    s_mov_b64 exec, -1
    v_readlane_b32 s40, v20, 0
    v_readlane_b32 s41, v20, 1
    v_readlane_b32 s42, v20, 2
    v_readlane_b32 s43, v20, 3
    s_nop 1
    s_branch L_decode
.section .rodata,"a"
.p2align 6
.amdhsa_kernel standalone__deepnorm__sampling_kernel
  .amdhsa_next_free_vgpr 52
  .amdhsa_next_free_sgpr 64
  .amdhsa_accum_offset 52
  .amdhsa_group_segment_fixed_size 0
  .amdhsa_kernarg_size 64
  .amdhsa_user_sgpr_count 2
  .amdhsa_user_sgpr_kernarg_segment_ptr 1
  .amdhsa_system_sgpr_workgroup_id_x 1
  .amdhsa_float_denorm_mode_32 3
  .amdhsa_float_denorm_mode_16_64 3
.end_amdhsa_kernel
```
